```python
import torch

def _softmax(x, axis=-1):
    return torch.softmax(x, dim=axis)
def _gelu(x):
    return torch.nn.functional.gelu(x, approximate="tanh")
def _silu(x):
    return torch.nn.functional.silu(x)
def _sigmoid(x):
    return torch.sigmoid(x)
def _layernorm(x, axis=-1, eps=1e-5):
    m = x.mean(dim=axis, keepdim=True)
    v = x.var(dim=axis, keepdim=True, unbiased=False)
    return (x - m) / torch.sqrt(v + eps)
def _scatter_add(tgt, idx, src, axis=0):
    return tgt.clone().index_add_(axis, idx, src)
def _segment_sum(src, seg, n):
    out = torch.zeros((n,) + src.shape[1:], dtype=src.dtype)
    return out.index_add_(0, seg, src)
def _pad(x, pw):
    flat = tuple(v for pair in reversed(pw) for v in pair)
    return torch.nn.functional.pad(x, flat)

kernel_name = 'standalone__softmax_full_bidir__decode'

def setup_inputs():

    _w = (lambda a: (lambda t: t.to(torch.bfloat16) if t.is_floating_point() else t)(torch.as_tensor(a)))
    B, H, Sq, Skv, Dh = 8, 32, 1, 4096, 128
    return {
        "q": _w((lambda *s: torch.randn(*s, dtype=torch.bfloat16) * 0.8)(B, H, Sq, Dh)),
        "k": _w((lambda *s: torch.randn(*s, dtype=torch.bfloat16) * 0.8)(B, H, Skv, Dh)),
        "v": _w((lambda *s: torch.randn(*s, dtype=torch.bfloat16) * 0.05)(B, H, Skv, Dh)),
    }

def reference(q, k, v):
    scale = q.shape[-1] ** -0.5
    scores = torch.einsum('bhqd,bhkd->bhqk', q, k) * scale
    attn = _softmax(scores, axis=-1)
    return torch.einsum('bhqk,bhkd->bhqd', attn, v)
```

```asm
; @launch grid=(256,1,1) block=(256,1,1) lds=18624
.amdgcn_target "amdgcn-amd-amdhsa--gfx950"
.text
.globl standalone__softmax_full_bidir__decode_kernel
.p2align 8
.type standalone__softmax_full_bidir__decode_kernel,@function
standalone__softmax_full_bidir__decode_kernel:
  s_cmp_ge_u32 s2, 256
  s_cbranch_scc1 L_end
  s_load_dwordx4 s[4:7], s[0:1], 0
  s_load_dwordx4 s[8:11], s[0:1], 16
  s_memrealtime s[36:37]
  s_mov_b32 s3, s2
  s_and_b32 s44, s2, 3
  s_lshl_b32 s44, s44, 2
  s_and_b32 s45, s2, 4
  s_lshl_b32 s45, s45, 5
  s_or_b32 s44, s44, s45
  s_bfe_u32 s45, s2, 0x20003
  s_or_b32 s44, s44, s45
  s_lshr_b32 s45, s2, 5
  s_lshl_b32 s45, s45, 4
  s_or_b32 s2, s44, s45
  v_and_b32 v16, 63, v0
  v_lshrrev_b32 v17, 6, v0
  v_lshlrev_b32 v1, 4, v16
  v_mul_u32_u24 v18, 2048, v17
  v_add_u32 v1, v1, v18
  v_and_b32 v19, 15, v0
  v_lshlrev_b32 v19, 4, v19
  v_lshlrev_b32 v30, 2, v16
  v_lshl_add_u32 v30, v17, 12, v30
  s_lshl_b32 s28, s2, 20
  s_lshl_b32 s29, s2, 8
  s_waitcnt lgkmcnt(0)
  s_add_u32 s12, s6, s28
  s_addc_u32 s13, s7, 0
  s_and_b32 s13, s13, 0xffff
  s_mov_b32 s14, 0x100000
  s_mov_b32 s15, 0x20000
  s_add_u32 s20, s4, s29
  s_addc_u32 s21, s5, 0
  s_and_b32 s21, s21, 0xffff
  s_mov_b32 s22, 256
  s_mov_b32 s23, 0x20000
  buffer_load_dwordx4 v[2:5], v19, s[20:23], 0 offen
  s_mov_b32 s47, 0
  buffer_load_dwordx4 v[32:35], v1, s[12:15], s47 offen offset:0 nt
  buffer_load_dwordx4 v[36:39], v1, s[12:15], s47 offen offset:1024 nt
  s_mov_b32 s47, 8192
  buffer_load_dwordx4 v[40:43], v1, s[12:15], s47 offen offset:0 nt
  buffer_load_dwordx4 v[44:47], v1, s[12:15], s47 offen offset:1024 nt
  s_mov_b32 s47, 16384
  buffer_load_dwordx4 v[48:51], v1, s[12:15], s47 offen offset:0 nt
  buffer_load_dwordx4 v[52:55], v1, s[12:15], s47 offen offset:1024 nt
  s_mov_b32 s47, 24576
  buffer_load_dwordx4 v[56:59], v1, s[12:15], s47 offen offset:0 nt
  buffer_load_dwordx4 v[60:63], v1, s[12:15], s47 offen offset:1024 nt
  s_add_u32 s16, s8, s28
  s_addc_u32 s17, s9, 0
  s_and_b32 s17, s17, 0xffff
  s_mov_b32 s18, 0x100000
  s_mov_b32 s19, 0x20000
  s_add_u32 s24, s10, s29
  s_addc_u32 s25, s11, 0
  s_and_b32 s25, s25, 0xffff
  s_mov_b32 s26, 256
  s_mov_b32 s27, 0x20000
  s_mov_b32 s50, s12
  s_mov_b32 s51, s13
  s_mov_b32 s28, 32768
  s_mov_b32 s29, 32768
  s_mov_b32 s30, 0x3e0293ee
  s_mov_b32 s31, 16
  s_mov_b32 s56, 0x00010001
  s_mov_b32 s57, 0x00010001
  s_mov_b32 s58, 0x00020002
  s_mov_b32 s59, 0x00020002
  s_mov_b32 s60, 0x00040004
  s_mov_b32 s61, 0x00040004
  s_mov_b32 s62, 0x00080008
  s_mov_b32 s63, 0x00080008
  s_mov_b32 s64, 0x00100010
  s_mov_b32 s65, 0x00100010
  s_mov_b32 s66, 0x00200020
  s_mov_b32 s67, 0x00200020
  s_mov_b32 s68, 0x00400040
  s_mov_b32 s69, 0x00400040
  s_mov_b32 s70, 0x00800080
  s_mov_b32 s71, 0x00800080
  s_mov_b32 s72, 0x01000100
  s_mov_b32 s73, 0x01000100
  s_mov_b32 s74, 0x02000200
  s_mov_b32 s75, 0x02000200
  s_mov_b32 s76, 0x04000400
  s_mov_b32 s77, 0x04000400
  s_mov_b32 s78, 0x08000800
  s_mov_b32 s79, 0x08000800
  s_mov_b32 s80, 0x10001000
  s_mov_b32 s81, 0x10001000
  s_mov_b32 s82, 0x20002000
  s_mov_b32 s83, 0x20002000
  s_mov_b32 s84, 0x40004000
  s_mov_b32 s85, 0x40004000
  s_mov_b32 s86, 0x80008000
  s_mov_b32 s87, 0x80008000
  v_mov_b32 v6, 0xff800000
  v_mov_b32 v7, 0
  v_mov_b32 v26, 0
  v_mov_b32 v8, 0
  v_mov_b32 v9, 0
  v_mov_b32 v10, 0
  v_mov_b32 v11, 0
  v_mov_b32 v12, 0
  v_mov_b32 v13, 0
  v_mov_b32 v14, 0
  v_mov_b32 v15, 0
  s_mov_b32 s46, 0
  s_mov_b32 s55, 800
L_p1:
  s_waitcnt vmcnt(6)
  v_dot2_f32_bf16 v28, v32, v2, 0
  v_dot2_f32_bf16 v29, v36, v2, 0
  v_dot2_f32_bf16 v28, v33, v3, v28
  v_dot2_f32_bf16 v29, v37, v3, v29
  v_dot2_f32_bf16 v28, v34, v4, v28
  v_dot2_f32_bf16 v29, v38, v4, v29
  v_dot2_f32_bf16 v28, v35, v5, v28
  v_dot2_f32_bf16 v29, v39, v5, v29
  s_nop 1
  s_bitcmp0_b32 s46, 0
  s_cbranch_scc1 L_nt1
  s_waitcnt vmcnt(4)
L_nt1:
  s_bitcmp0_b32 s46, 4
  s_cbranch_scc1 L_nt2
  s_waitcnt vmcnt(2)
L_nt2:
  s_cmp_ge_u32 s28, 0x100000
  s_cselect_b64 s[12:13], s[16:17], s[50:51]
  s_and_b32 s47, s28, 0xfffff
  buffer_load_dwordx4 v[32:35], v1, s[12:15], s47 offen offset:0 nt
  buffer_load_dwordx4 v[36:39], v1, s[12:15], s47 offen offset:1024 nt
  s_add_u32 s28, s28, 8192
  v_add_f32_dpp v28, v28, v28 quad_perm:[1,0,3,2] row_mask:0xf bank_mask:0xf
  v_add_f32_dpp v29, v29, v29 quad_perm:[1,0,3,2] row_mask:0xf bank_mask:0xf
  s_nop 0
  v_add_f32_dpp v28, v28, v28 quad_perm:[2,3,0,1] row_mask:0xf bank_mask:0xf
  v_add_f32_dpp v29, v29, v29 quad_perm:[2,3,0,1] row_mask:0xf bank_mask:0xf
  s_nop 0
  v_add_f32_dpp v28, v28, v28 row_half_mirror row_mask:0xf bank_mask:0xf
  v_add_f32_dpp v29, v29, v29 row_half_mirror row_mask:0xf bank_mask:0xf
  s_nop 0
  v_add_f32_dpp v28, v28, v28 row_mirror row_mask:0xf bank_mask:0xf
  v_add_f32_dpp v29, v29, v29 row_mirror row_mask:0xf bank_mask:0xf
  s_nop 0
  v_cndmask_b32 v26, v26, v28, s[56:57]
  v_cndmask_b32 v26, v26, v29, s[58:59]
  s_waitcnt vmcnt(6)
  v_dot2_f32_bf16 v28, v40, v2, 0
  v_dot2_f32_bf16 v29, v44, v2, 0
  v_dot2_f32_bf16 v28, v41, v3, v28
  v_dot2_f32_bf16 v29, v45, v3, v29
  v_dot2_f32_bf16 v28, v42, v4, v28
  v_dot2_f32_bf16 v29, v46, v4, v29
  v_dot2_f32_bf16 v28, v43, v5, v28
  v_dot2_f32_bf16 v29, v47, v5, v29
  s_nop 1
  s_bitcmp0_b32 s46, 1
  s_cbranch_scc1 L_nt3
  s_waitcnt vmcnt(4)
L_nt3:
  s_bitcmp0_b32 s46, 5
  s_cbranch_scc1 L_nt4
  s_waitcnt vmcnt(2)
L_nt4:
  s_cmp_ge_u32 s28, 0x100000
  s_cselect_b64 s[12:13], s[16:17], s[50:51]
  s_and_b32 s47, s28, 0xfffff
  buffer_load_dwordx4 v[40:43], v1, s[12:15], s47 offen offset:0 nt
  buffer_load_dwordx4 v[44:47], v1, s[12:15], s47 offen offset:1024 nt
  s_add_u32 s28, s28, 8192
  v_add_f32_dpp v28, v28, v28 quad_perm:[1,0,3,2] row_mask:0xf bank_mask:0xf
  v_add_f32_dpp v29, v29, v29 quad_perm:[1,0,3,2] row_mask:0xf bank_mask:0xf
  s_nop 0
  v_add_f32_dpp v28, v28, v28 quad_perm:[2,3,0,1] row_mask:0xf bank_mask:0xf
  v_add_f32_dpp v29, v29, v29 quad_perm:[2,3,0,1] row_mask:0xf bank_mask:0xf
  s_nop 0
  v_add_f32_dpp v28, v28, v28 row_half_mirror row_mask:0xf bank_mask:0xf
  v_add_f32_dpp v29, v29, v29 row_half_mirror row_mask:0xf bank_mask:0xf
  s_nop 0
  v_add_f32_dpp v28, v28, v28 row_mirror row_mask:0xf bank_mask:0xf
  v_add_f32_dpp v29, v29, v29 row_mirror row_mask:0xf bank_mask:0xf
  s_nop 0
  v_cndmask_b32 v26, v26, v28, s[60:61]
  v_cndmask_b32 v26, v26, v29, s[62:63]
  s_waitcnt vmcnt(6)
  v_dot2_f32_bf16 v28, v48, v2, 0
  v_dot2_f32_bf16 v29, v52, v2, 0
  v_dot2_f32_bf16 v28, v49, v3, v28
  v_dot2_f32_bf16 v29, v53, v3, v29
  v_dot2_f32_bf16 v28, v50, v4, v28
  v_dot2_f32_bf16 v29, v54, v4, v29
  v_dot2_f32_bf16 v28, v51, v5, v28
  v_dot2_f32_bf16 v29, v55, v5, v29
  s_nop 1
  s_bitcmp0_b32 s46, 2
  s_cbranch_scc1 L_nt5
  s_waitcnt vmcnt(4)
L_nt5:
  s_bitcmp0_b32 s46, 6
  s_cbranch_scc1 L_nt6
  s_waitcnt vmcnt(2)
L_nt6:
  s_cmp_ge_u32 s28, 0x100000
  s_cselect_b64 s[12:13], s[16:17], s[50:51]
  s_and_b32 s47, s28, 0xfffff
  buffer_load_dwordx4 v[48:51], v1, s[12:15], s47 offen offset:0 nt
  buffer_load_dwordx4 v[52:55], v1, s[12:15], s47 offen offset:1024 nt
  s_add_u32 s28, s28, 8192
  v_add_f32_dpp v28, v28, v28 quad_perm:[1,0,3,2] row_mask:0xf bank_mask:0xf
  v_add_f32_dpp v29, v29, v29 quad_perm:[1,0,3,2] row_mask:0xf bank_mask:0xf
  s_nop 0
  v_add_f32_dpp v28, v28, v28 quad_perm:[2,3,0,1] row_mask:0xf bank_mask:0xf
  v_add_f32_dpp v29, v29, v29 quad_perm:[2,3,0,1] row_mask:0xf bank_mask:0xf
  s_nop 0
  v_add_f32_dpp v28, v28, v28 row_half_mirror row_mask:0xf bank_mask:0xf
  v_add_f32_dpp v29, v29, v29 row_half_mirror row_mask:0xf bank_mask:0xf
  s_nop 0
  v_add_f32_dpp v28, v28, v28 row_mirror row_mask:0xf bank_mask:0xf
  v_add_f32_dpp v29, v29, v29 row_mirror row_mask:0xf bank_mask:0xf
  s_nop 0
  v_cndmask_b32 v26, v26, v28, s[64:65]
  v_cndmask_b32 v26, v26, v29, s[66:67]
  s_waitcnt vmcnt(6)
  v_dot2_f32_bf16 v28, v56, v2, 0
  v_dot2_f32_bf16 v29, v60, v2, 0
  v_dot2_f32_bf16 v28, v57, v3, v28
  v_dot2_f32_bf16 v29, v61, v3, v29
  v_dot2_f32_bf16 v28, v58, v4, v28
  v_dot2_f32_bf16 v29, v62, v4, v29
  v_dot2_f32_bf16 v28, v59, v5, v28
  v_dot2_f32_bf16 v29, v63, v5, v29
  s_nop 1
  s_bitcmp0_b32 s46, 3
  s_cbranch_scc1 L_nt7
  s_waitcnt vmcnt(4)
L_nt7:
  s_bitcmp0_b32 s46, 7
  s_cbranch_scc1 L_nt8
  s_waitcnt vmcnt(2)
L_nt8:
  s_cmp_ge_u32 s28, 0x100000
  s_cselect_b64 s[12:13], s[16:17], s[50:51]
  s_and_b32 s47, s28, 0xfffff
  buffer_load_dwordx4 v[56:59], v1, s[12:15], s47 offen offset:0 nt
  buffer_load_dwordx4 v[60:63], v1, s[12:15], s47 offen offset:1024 nt
  s_add_u32 s28, s28, 8192
  v_add_f32_dpp v28, v28, v28 quad_perm:[1,0,3,2] row_mask:0xf bank_mask:0xf
  v_add_f32_dpp v29, v29, v29 quad_perm:[1,0,3,2] row_mask:0xf bank_mask:0xf
  s_nop 0
  v_add_f32_dpp v28, v28, v28 quad_perm:[2,3,0,1] row_mask:0xf bank_mask:0xf
  v_add_f32_dpp v29, v29, v29 quad_perm:[2,3,0,1] row_mask:0xf bank_mask:0xf
  s_nop 0
  v_add_f32_dpp v28, v28, v28 row_half_mirror row_mask:0xf bank_mask:0xf
  v_add_f32_dpp v29, v29, v29 row_half_mirror row_mask:0xf bank_mask:0xf
  s_nop 0
  v_add_f32_dpp v28, v28, v28 row_mirror row_mask:0xf bank_mask:0xf
  v_add_f32_dpp v29, v29, v29 row_mirror row_mask:0xf bank_mask:0xf
  s_nop 0
  v_cndmask_b32 v26, v26, v28, s[68:69]
  v_cndmask_b32 v26, v26, v29, s[70:71]
  s_waitcnt vmcnt(6)
  v_dot2_f32_bf16 v28, v32, v2, 0
  v_dot2_f32_bf16 v29, v36, v2, 0
  v_dot2_f32_bf16 v28, v33, v3, v28
  v_dot2_f32_bf16 v29, v37, v3, v29
  v_dot2_f32_bf16 v28, v34, v4, v28
  v_dot2_f32_bf16 v29, v38, v4, v29
  v_dot2_f32_bf16 v28, v35, v5, v28
  v_dot2_f32_bf16 v29, v39, v5, v29
  s_nop 1
  s_bitcmp0_b32 s46, 0
  s_cbranch_scc1 L_nt9
  s_waitcnt vmcnt(4)
L_nt9:
  s_bitcmp0_b32 s46, 4
  s_cbranch_scc1 L_nt10
  s_waitcnt vmcnt(2)
L_nt10:
  s_cmp_ge_u32 s28, 0x100000
  s_cselect_b64 s[12:13], s[16:17], s[50:51]
  s_and_b32 s47, s28, 0xfffff
  buffer_load_dwordx4 v[32:35], v1, s[12:15], s47 offen offset:0 nt
  buffer_load_dwordx4 v[36:39], v1, s[12:15], s47 offen offset:1024 nt
  s_add_u32 s28, s28, 8192
  v_add_f32_dpp v28, v28, v28 quad_perm:[1,0,3,2] row_mask:0xf bank_mask:0xf
  v_add_f32_dpp v29, v29, v29 quad_perm:[1,0,3,2] row_mask:0xf bank_mask:0xf
  s_nop 0
  v_add_f32_dpp v28, v28, v28 quad_perm:[2,3,0,1] row_mask:0xf bank_mask:0xf
  v_add_f32_dpp v29, v29, v29 quad_perm:[2,3,0,1] row_mask:0xf bank_mask:0xf
  s_nop 0
  v_add_f32_dpp v28, v28, v28 row_half_mirror row_mask:0xf bank_mask:0xf
  v_add_f32_dpp v29, v29, v29 row_half_mirror row_mask:0xf bank_mask:0xf
  s_nop 0
  v_add_f32_dpp v28, v28, v28 row_mirror row_mask:0xf bank_mask:0xf
  v_add_f32_dpp v29, v29, v29 row_mirror row_mask:0xf bank_mask:0xf
  s_nop 0
  v_cndmask_b32 v26, v26, v28, s[72:73]
  v_cndmask_b32 v26, v26, v29, s[74:75]
  s_waitcnt vmcnt(6)
  v_dot2_f32_bf16 v28, v40, v2, 0
  v_dot2_f32_bf16 v29, v44, v2, 0
  v_dot2_f32_bf16 v28, v41, v3, v28
  v_dot2_f32_bf16 v29, v45, v3, v29
  v_dot2_f32_bf16 v28, v42, v4, v28
  v_dot2_f32_bf16 v29, v46, v4, v29
  v_dot2_f32_bf16 v28, v43, v5, v28
  v_dot2_f32_bf16 v29, v47, v5, v29
  s_nop 1
  s_bitcmp0_b32 s46, 1
  s_cbranch_scc1 L_nt11
  s_waitcnt vmcnt(4)
L_nt11:
  s_bitcmp0_b32 s46, 5
  s_cbranch_scc1 L_nt12
  s_waitcnt vmcnt(2)
L_nt12:
  s_cmp_ge_u32 s28, 0x100000
  s_cselect_b64 s[12:13], s[16:17], s[50:51]
  s_and_b32 s47, s28, 0xfffff
  buffer_load_dwordx4 v[40:43], v1, s[12:15], s47 offen offset:0 nt
  buffer_load_dwordx4 v[44:47], v1, s[12:15], s47 offen offset:1024 nt
  s_add_u32 s28, s28, 8192
  v_add_f32_dpp v28, v28, v28 quad_perm:[1,0,3,2] row_mask:0xf bank_mask:0xf
  v_add_f32_dpp v29, v29, v29 quad_perm:[1,0,3,2] row_mask:0xf bank_mask:0xf
  s_nop 0
  v_add_f32_dpp v28, v28, v28 quad_perm:[2,3,0,1] row_mask:0xf bank_mask:0xf
  v_add_f32_dpp v29, v29, v29 quad_perm:[2,3,0,1] row_mask:0xf bank_mask:0xf
  s_nop 0
  v_add_f32_dpp v28, v28, v28 row_half_mirror row_mask:0xf bank_mask:0xf
  v_add_f32_dpp v29, v29, v29 row_half_mirror row_mask:0xf bank_mask:0xf
  s_nop 0
  v_add_f32_dpp v28, v28, v28 row_mirror row_mask:0xf bank_mask:0xf
  v_add_f32_dpp v29, v29, v29 row_mirror row_mask:0xf bank_mask:0xf
  s_nop 0
  v_cndmask_b32 v26, v26, v28, s[76:77]
  v_cndmask_b32 v26, v26, v29, s[78:79]
  s_waitcnt vmcnt(6)
  v_dot2_f32_bf16 v28, v48, v2, 0
  v_dot2_f32_bf16 v29, v52, v2, 0
  v_dot2_f32_bf16 v28, v49, v3, v28
  v_dot2_f32_bf16 v29, v53, v3, v29
  v_dot2_f32_bf16 v28, v50, v4, v28
  v_dot2_f32_bf16 v29, v54, v4, v29
  v_dot2_f32_bf16 v28, v51, v5, v28
  v_dot2_f32_bf16 v29, v55, v5, v29
  s_nop 1
  s_bitcmp0_b32 s46, 2
  s_cbranch_scc1 L_nt13
  s_waitcnt vmcnt(4)
L_nt13:
  s_bitcmp0_b32 s46, 6
  s_cbranch_scc1 L_nt14
  s_waitcnt vmcnt(2)
L_nt14:
  s_cmp_ge_u32 s28, 0x100000
  s_cselect_b64 s[12:13], s[16:17], s[50:51]
  s_and_b32 s47, s28, 0xfffff
  buffer_load_dwordx4 v[48:51], v1, s[12:15], s47 offen offset:0 nt
  buffer_load_dwordx4 v[52:55], v1, s[12:15], s47 offen offset:1024 nt
  s_add_u32 s28, s28, 8192
  v_add_f32_dpp v28, v28, v28 quad_perm:[1,0,3,2] row_mask:0xf bank_mask:0xf
  v_add_f32_dpp v29, v29, v29 quad_perm:[1,0,3,2] row_mask:0xf bank_mask:0xf
  s_nop 0
  v_add_f32_dpp v28, v28, v28 quad_perm:[2,3,0,1] row_mask:0xf bank_mask:0xf
  v_add_f32_dpp v29, v29, v29 quad_perm:[2,3,0,1] row_mask:0xf bank_mask:0xf
  s_nop 0
  v_add_f32_dpp v28, v28, v28 row_half_mirror row_mask:0xf bank_mask:0xf
  v_add_f32_dpp v29, v29, v29 row_half_mirror row_mask:0xf bank_mask:0xf
  s_nop 0
  v_add_f32_dpp v28, v28, v28 row_mirror row_mask:0xf bank_mask:0xf
  v_add_f32_dpp v29, v29, v29 row_mirror row_mask:0xf bank_mask:0xf
  s_nop 0
  v_cndmask_b32 v26, v26, v28, s[80:81]
  v_cndmask_b32 v26, v26, v29, s[82:83]
  s_memrealtime s[52:53]
  s_waitcnt vmcnt(6)
  v_dot2_f32_bf16 v28, v56, v2, 0
  v_dot2_f32_bf16 v29, v60, v2, 0
  v_dot2_f32_bf16 v28, v57, v3, v28
  v_dot2_f32_bf16 v29, v61, v3, v29
  v_dot2_f32_bf16 v28, v58, v4, v28
  v_dot2_f32_bf16 v29, v62, v4, v29
  v_dot2_f32_bf16 v28, v59, v5, v28
  v_dot2_f32_bf16 v29, v63, v5, v29
  s_nop 1
  s_bitcmp0_b32 s46, 3
  s_cbranch_scc1 L_nt15
  s_waitcnt vmcnt(4)
L_nt15:
  s_bitcmp0_b32 s46, 7
  s_cbranch_scc1 L_nt16
  s_waitcnt vmcnt(2)
L_nt16:
  s_cmp_ge_u32 s28, 0x100000
  s_cselect_b64 s[12:13], s[16:17], s[50:51]
  s_and_b32 s47, s28, 0xfffff
  buffer_load_dwordx4 v[56:59], v1, s[12:15], s47 offen offset:0 nt
  buffer_load_dwordx4 v[60:63], v1, s[12:15], s47 offen offset:1024 nt
  s_add_u32 s28, s28, 8192
  v_add_f32_dpp v28, v28, v28 quad_perm:[1,0,3,2] row_mask:0xf bank_mask:0xf
  v_add_f32_dpp v29, v29, v29 quad_perm:[1,0,3,2] row_mask:0xf bank_mask:0xf
  s_nop 0
  v_add_f32_dpp v28, v28, v28 quad_perm:[2,3,0,1] row_mask:0xf bank_mask:0xf
  v_add_f32_dpp v29, v29, v29 quad_perm:[2,3,0,1] row_mask:0xf bank_mask:0xf
  s_nop 0
  v_add_f32_dpp v28, v28, v28 row_half_mirror row_mask:0xf bank_mask:0xf
  v_add_f32_dpp v29, v29, v29 row_half_mirror row_mask:0xf bank_mask:0xf
  s_nop 0
  v_add_f32_dpp v28, v28, v28 row_mirror row_mask:0xf bank_mask:0xf
  v_add_f32_dpp v29, v29, v29 row_mirror row_mask:0xf bank_mask:0xf
  s_nop 0
  v_cndmask_b32 v26, v26, v28, s[84:85]
  v_cndmask_b32 v26, v26, v29, s[86:87]
  ds_write_b32 v30, v26
  v_max_f32 v6, v6, v26
  v_add_u32 v30, 256, v30
  s_waitcnt lgkmcnt(0)
  s_sub_u32 s54, s52, s36
  s_lshl_b32 s54, s54, 3
  s_add_u32 s55, s55, 1769
  s_cmp_lt_u32 s54, s55
  s_cselect_b32 s46, 15, 0
  s_sub_u32 s53, s55, 640
  s_cmp_lt_i32 s54, s53
  s_cselect_b32 s46, 240, s46
  s_sub_u32 s31, s31, 1
  s_cmp_lg_u32 s31, 0
  s_cbranch_scc1 L_p1
  v_subrev_u32 v30, 4096, v30
  ds_read_b32 v27, v30
  s_nop 1
  v_max_f32_dpp v6, v6, v6 quad_perm:[1,0,3,2] row_mask:0xf bank_mask:0xf
  s_nop 1
  v_max_f32_dpp v6, v6, v6 quad_perm:[2,3,0,1] row_mask:0xf bank_mask:0xf
  s_nop 1
  v_max_f32_dpp v6, v6, v6 row_half_mirror row_mask:0xf bank_mask:0xf
  s_nop 1
  v_max_f32_dpp v6, v6, v6 row_mirror row_mask:0xf bank_mask:0xf
  v_mov_b32 v17, v6
  s_nop 1
  v_permlane16_swap_b32 v6, v17
  s_nop 1
  v_max_f32 v6, v6, v17
  v_mov_b32 v17, v6
  s_nop 1
  v_permlane32_swap_b32 v6, v17
  s_nop 1
  v_max_f32 v24, v6, v17
  v_mul_f32 v25, s30, v24
  s_mov_b32 s31, 16
L_p2:
  s_waitcnt lgkmcnt(0)
  v_fma_f32 v26, v27, s30, -v25
  v_add_u32 v30, 256, v30
  v_exp_f32 v26, v26
  ds_read_b32 v27, v30
  s_nop 0
  v_add_f32 v7, v7, v26
  s_waitcnt vmcnt(6)
  v_lshlrev_b32 v16, 16, v32
  v_and_b32 v17, 0xffff0000, v32
  v_fmac_f32_dpp v8, v26, v16 row_newbcast:0 row_mask:0xf bank_mask:0xf
  v_fmac_f32_dpp v9, v26, v17 row_newbcast:0 row_mask:0xf bank_mask:0xf
  v_lshlrev_b32 v18, 16, v33
  v_and_b32 v19, 0xffff0000, v33
  v_fmac_f32_dpp v10, v26, v18 row_newbcast:0 row_mask:0xf bank_mask:0xf
  v_fmac_f32_dpp v11, v26, v19 row_newbcast:0 row_mask:0xf bank_mask:0xf
  v_lshlrev_b32 v16, 16, v34
  v_and_b32 v17, 0xffff0000, v34
  v_fmac_f32_dpp v12, v26, v16 row_newbcast:0 row_mask:0xf bank_mask:0xf
  v_fmac_f32_dpp v13, v26, v17 row_newbcast:0 row_mask:0xf bank_mask:0xf
  v_lshlrev_b32 v18, 16, v35
  v_and_b32 v19, 0xffff0000, v35
  v_fmac_f32_dpp v14, v26, v18 row_newbcast:0 row_mask:0xf bank_mask:0xf
  v_fmac_f32_dpp v15, v26, v19 row_newbcast:0 row_mask:0xf bank_mask:0xf
  v_lshlrev_b32 v16, 16, v36
  v_and_b32 v17, 0xffff0000, v36
  v_fmac_f32_dpp v8, v26, v16 row_newbcast:1 row_mask:0xf bank_mask:0xf
  v_fmac_f32_dpp v9, v26, v17 row_newbcast:1 row_mask:0xf bank_mask:0xf
  v_lshlrev_b32 v18, 16, v37
  v_and_b32 v19, 0xffff0000, v37
  v_fmac_f32_dpp v10, v26, v18 row_newbcast:1 row_mask:0xf bank_mask:0xf
  v_fmac_f32_dpp v11, v26, v19 row_newbcast:1 row_mask:0xf bank_mask:0xf
  v_lshlrev_b32 v16, 16, v38
  v_and_b32 v17, 0xffff0000, v38
  v_fmac_f32_dpp v12, v26, v16 row_newbcast:1 row_mask:0xf bank_mask:0xf
  v_fmac_f32_dpp v13, v26, v17 row_newbcast:1 row_mask:0xf bank_mask:0xf
  v_lshlrev_b32 v18, 16, v39
  v_and_b32 v19, 0xffff0000, v39
  v_fmac_f32_dpp v14, v26, v18 row_newbcast:1 row_mask:0xf bank_mask:0xf
  v_fmac_f32_dpp v15, v26, v19 row_newbcast:1 row_mask:0xf bank_mask:0xf
  s_bitcmp0_b32 s46, 0
  s_cbranch_scc1 L_nt17
  s_waitcnt vmcnt(4)
L_nt17:
  s_bitcmp0_b32 s46, 4
  s_cbranch_scc1 L_nt18
  s_waitcnt vmcnt(2)
L_nt18:
  buffer_load_dwordx4 v[32:35], v1, s[16:19], s29 offen offset:0 nt
  buffer_load_dwordx4 v[36:39], v1, s[16:19], s29 offen offset:1024 nt
  s_add_u32 s29, s29, 8192
  s_waitcnt vmcnt(6)
  v_lshlrev_b32 v16, 16, v40
  v_and_b32 v17, 0xffff0000, v40
  v_fmac_f32_dpp v8, v26, v16 row_newbcast:2 row_mask:0xf bank_mask:0xf
  v_fmac_f32_dpp v9, v26, v17 row_newbcast:2 row_mask:0xf bank_mask:0xf
  v_lshlrev_b32 v18, 16, v41
  v_and_b32 v19, 0xffff0000, v41
  v_fmac_f32_dpp v10, v26, v18 row_newbcast:2 row_mask:0xf bank_mask:0xf
  v_fmac_f32_dpp v11, v26, v19 row_newbcast:2 row_mask:0xf bank_mask:0xf
  v_lshlrev_b32 v16, 16, v42
  v_and_b32 v17, 0xffff0000, v42
  v_fmac_f32_dpp v12, v26, v16 row_newbcast:2 row_mask:0xf bank_mask:0xf
  v_fmac_f32_dpp v13, v26, v17 row_newbcast:2 row_mask:0xf bank_mask:0xf
  v_lshlrev_b32 v18, 16, v43
  v_and_b32 v19, 0xffff0000, v43
  v_fmac_f32_dpp v14, v26, v18 row_newbcast:2 row_mask:0xf bank_mask:0xf
  v_fmac_f32_dpp v15, v26, v19 row_newbcast:2 row_mask:0xf bank_mask:0xf
  v_lshlrev_b32 v16, 16, v44
  v_and_b32 v17, 0xffff0000, v44
  v_fmac_f32_dpp v8, v26, v16 row_newbcast:3 row_mask:0xf bank_mask:0xf
  v_fmac_f32_dpp v9, v26, v17 row_newbcast:3 row_mask:0xf bank_mask:0xf
  v_lshlrev_b32 v18, 16, v45
  v_and_b32 v19, 0xffff0000, v45
  v_fmac_f32_dpp v10, v26, v18 row_newbcast:3 row_mask:0xf bank_mask:0xf
  v_fmac_f32_dpp v11, v26, v19 row_newbcast:3 row_mask:0xf bank_mask:0xf
  v_lshlrev_b32 v16, 16, v46
  v_and_b32 v17, 0xffff0000, v46
  v_fmac_f32_dpp v12, v26, v16 row_newbcast:3 row_mask:0xf bank_mask:0xf
  v_fmac_f32_dpp v13, v26, v17 row_newbcast:3 row_mask:0xf bank_mask:0xf
  v_lshlrev_b32 v18, 16, v47
  v_and_b32 v19, 0xffff0000, v47
  v_fmac_f32_dpp v14, v26, v18 row_newbcast:3 row_mask:0xf bank_mask:0xf
  v_fmac_f32_dpp v15, v26, v19 row_newbcast:3 row_mask:0xf bank_mask:0xf
  s_bitcmp0_b32 s46, 1
  s_cbranch_scc1 L_nt19
  s_waitcnt vmcnt(4)
L_nt19:
  s_bitcmp0_b32 s46, 5
  s_cbranch_scc1 L_nt20
  s_waitcnt vmcnt(2)
L_nt20:
  buffer_load_dwordx4 v[40:43], v1, s[16:19], s29 offen offset:0 nt
  buffer_load_dwordx4 v[44:47], v1, s[16:19], s29 offen offset:1024 nt
  s_add_u32 s29, s29, 8192
  s_waitcnt vmcnt(6)
  v_lshlrev_b32 v16, 16, v48
  v_and_b32 v17, 0xffff0000, v48
  v_fmac_f32_dpp v8, v26, v16 row_newbcast:4 row_mask:0xf bank_mask:0xf
  v_fmac_f32_dpp v9, v26, v17 row_newbcast:4 row_mask:0xf bank_mask:0xf
  v_lshlrev_b32 v18, 16, v49
  v_and_b32 v19, 0xffff0000, v49
  v_fmac_f32_dpp v10, v26, v18 row_newbcast:4 row_mask:0xf bank_mask:0xf
  v_fmac_f32_dpp v11, v26, v19 row_newbcast:4 row_mask:0xf bank_mask:0xf
  v_lshlrev_b32 v16, 16, v50
  v_and_b32 v17, 0xffff0000, v50
  v_fmac_f32_dpp v12, v26, v16 row_newbcast:4 row_mask:0xf bank_mask:0xf
  v_fmac_f32_dpp v13, v26, v17 row_newbcast:4 row_mask:0xf bank_mask:0xf
  v_lshlrev_b32 v18, 16, v51
  v_and_b32 v19, 0xffff0000, v51
  v_fmac_f32_dpp v14, v26, v18 row_newbcast:4 row_mask:0xf bank_mask:0xf
  v_fmac_f32_dpp v15, v26, v19 row_newbcast:4 row_mask:0xf bank_mask:0xf
  v_lshlrev_b32 v16, 16, v52
  v_and_b32 v17, 0xffff0000, v52
  v_fmac_f32_dpp v8, v26, v16 row_newbcast:5 row_mask:0xf bank_mask:0xf
  v_fmac_f32_dpp v9, v26, v17 row_newbcast:5 row_mask:0xf bank_mask:0xf
  v_lshlrev_b32 v18, 16, v53
  v_and_b32 v19, 0xffff0000, v53
  v_fmac_f32_dpp v10, v26, v18 row_newbcast:5 row_mask:0xf bank_mask:0xf
  v_fmac_f32_dpp v11, v26, v19 row_newbcast:5 row_mask:0xf bank_mask:0xf
  v_lshlrev_b32 v16, 16, v54
  v_and_b32 v17, 0xffff0000, v54
  v_fmac_f32_dpp v12, v26, v16 row_newbcast:5 row_mask:0xf bank_mask:0xf
  v_fmac_f32_dpp v13, v26, v17 row_newbcast:5 row_mask:0xf bank_mask:0xf
  v_lshlrev_b32 v18, 16, v55
  v_and_b32 v19, 0xffff0000, v55
  v_fmac_f32_dpp v14, v26, v18 row_newbcast:5 row_mask:0xf bank_mask:0xf
  v_fmac_f32_dpp v15, v26, v19 row_newbcast:5 row_mask:0xf bank_mask:0xf
  s_bitcmp0_b32 s46, 2
  s_cbranch_scc1 L_nt21
  s_waitcnt vmcnt(4)
L_nt21:
  s_bitcmp0_b32 s46, 6
  s_cbranch_scc1 L_nt22
  s_waitcnt vmcnt(2)
L_nt22:
  buffer_load_dwordx4 v[48:51], v1, s[16:19], s29 offen offset:0 nt
  buffer_load_dwordx4 v[52:55], v1, s[16:19], s29 offen offset:1024 nt
  s_add_u32 s29, s29, 8192
  s_waitcnt vmcnt(6)
  v_lshlrev_b32 v16, 16, v56
  v_and_b32 v17, 0xffff0000, v56
  v_fmac_f32_dpp v8, v26, v16 row_newbcast:6 row_mask:0xf bank_mask:0xf
  v_fmac_f32_dpp v9, v26, v17 row_newbcast:6 row_mask:0xf bank_mask:0xf
  v_lshlrev_b32 v18, 16, v57
  v_and_b32 v19, 0xffff0000, v57
  v_fmac_f32_dpp v10, v26, v18 row_newbcast:6 row_mask:0xf bank_mask:0xf
  v_fmac_f32_dpp v11, v26, v19 row_newbcast:6 row_mask:0xf bank_mask:0xf
  v_lshlrev_b32 v16, 16, v58
  v_and_b32 v17, 0xffff0000, v58
  v_fmac_f32_dpp v12, v26, v16 row_newbcast:6 row_mask:0xf bank_mask:0xf
  v_fmac_f32_dpp v13, v26, v17 row_newbcast:6 row_mask:0xf bank_mask:0xf
  v_lshlrev_b32 v18, 16, v59
  v_and_b32 v19, 0xffff0000, v59
  v_fmac_f32_dpp v14, v26, v18 row_newbcast:6 row_mask:0xf bank_mask:0xf
  v_fmac_f32_dpp v15, v26, v19 row_newbcast:6 row_mask:0xf bank_mask:0xf
  v_lshlrev_b32 v16, 16, v60
  v_and_b32 v17, 0xffff0000, v60
  v_fmac_f32_dpp v8, v26, v16 row_newbcast:7 row_mask:0xf bank_mask:0xf
  v_fmac_f32_dpp v9, v26, v17 row_newbcast:7 row_mask:0xf bank_mask:0xf
  v_lshlrev_b32 v18, 16, v61
  v_and_b32 v19, 0xffff0000, v61
  v_fmac_f32_dpp v10, v26, v18 row_newbcast:7 row_mask:0xf bank_mask:0xf
  v_fmac_f32_dpp v11, v26, v19 row_newbcast:7 row_mask:0xf bank_mask:0xf
  v_lshlrev_b32 v16, 16, v62
  v_and_b32 v17, 0xffff0000, v62
  v_fmac_f32_dpp v12, v26, v16 row_newbcast:7 row_mask:0xf bank_mask:0xf
  v_fmac_f32_dpp v13, v26, v17 row_newbcast:7 row_mask:0xf bank_mask:0xf
  v_lshlrev_b32 v18, 16, v63
  v_and_b32 v19, 0xffff0000, v63
  v_fmac_f32_dpp v14, v26, v18 row_newbcast:7 row_mask:0xf bank_mask:0xf
  v_fmac_f32_dpp v15, v26, v19 row_newbcast:7 row_mask:0xf bank_mask:0xf
  s_bitcmp0_b32 s46, 3
  s_cbranch_scc1 L_nt23
  s_waitcnt vmcnt(4)
L_nt23:
  s_bitcmp0_b32 s46, 7
  s_cbranch_scc1 L_nt24
  s_waitcnt vmcnt(2)
L_nt24:
  buffer_load_dwordx4 v[56:59], v1, s[16:19], s29 offen offset:0 nt
  buffer_load_dwordx4 v[60:63], v1, s[16:19], s29 offen offset:1024 nt
  s_add_u32 s29, s29, 8192
  s_waitcnt vmcnt(6)
  v_lshlrev_b32 v16, 16, v32
  v_and_b32 v17, 0xffff0000, v32
  v_fmac_f32_dpp v8, v26, v16 row_newbcast:8 row_mask:0xf bank_mask:0xf
  v_fmac_f32_dpp v9, v26, v17 row_newbcast:8 row_mask:0xf bank_mask:0xf
  v_lshlrev_b32 v18, 16, v33
  v_and_b32 v19, 0xffff0000, v33
  v_fmac_f32_dpp v10, v26, v18 row_newbcast:8 row_mask:0xf bank_mask:0xf
  v_fmac_f32_dpp v11, v26, v19 row_newbcast:8 row_mask:0xf bank_mask:0xf
  v_lshlrev_b32 v16, 16, v34
  v_and_b32 v17, 0xffff0000, v34
  v_fmac_f32_dpp v12, v26, v16 row_newbcast:8 row_mask:0xf bank_mask:0xf
  v_fmac_f32_dpp v13, v26, v17 row_newbcast:8 row_mask:0xf bank_mask:0xf
  v_lshlrev_b32 v18, 16, v35
  v_and_b32 v19, 0xffff0000, v35
  v_fmac_f32_dpp v14, v26, v18 row_newbcast:8 row_mask:0xf bank_mask:0xf
  v_fmac_f32_dpp v15, v26, v19 row_newbcast:8 row_mask:0xf bank_mask:0xf
  v_lshlrev_b32 v16, 16, v36
  v_and_b32 v17, 0xffff0000, v36
  v_fmac_f32_dpp v8, v26, v16 row_newbcast:9 row_mask:0xf bank_mask:0xf
  v_fmac_f32_dpp v9, v26, v17 row_newbcast:9 row_mask:0xf bank_mask:0xf
  v_lshlrev_b32 v18, 16, v37
  v_and_b32 v19, 0xffff0000, v37
  v_fmac_f32_dpp v10, v26, v18 row_newbcast:9 row_mask:0xf bank_mask:0xf
  v_fmac_f32_dpp v11, v26, v19 row_newbcast:9 row_mask:0xf bank_mask:0xf
  v_lshlrev_b32 v16, 16, v38
  v_and_b32 v17, 0xffff0000, v38
  v_fmac_f32_dpp v12, v26, v16 row_newbcast:9 row_mask:0xf bank_mask:0xf
  v_fmac_f32_dpp v13, v26, v17 row_newbcast:9 row_mask:0xf bank_mask:0xf
  v_lshlrev_b32 v18, 16, v39
  v_and_b32 v19, 0xffff0000, v39
  v_fmac_f32_dpp v14, v26, v18 row_newbcast:9 row_mask:0xf bank_mask:0xf
  v_fmac_f32_dpp v15, v26, v19 row_newbcast:9 row_mask:0xf bank_mask:0xf
  s_bitcmp0_b32 s46, 0
  s_cbranch_scc1 L_nt25
  s_waitcnt vmcnt(4)
L_nt25:
  s_bitcmp0_b32 s46, 4
  s_cbranch_scc1 L_nt26
  s_waitcnt vmcnt(2)
L_nt26:
  buffer_load_dwordx4 v[32:35], v1, s[16:19], s29 offen offset:0 nt
  buffer_load_dwordx4 v[36:39], v1, s[16:19], s29 offen offset:1024 nt
  s_add_u32 s29, s29, 8192
  s_waitcnt vmcnt(6)
  v_lshlrev_b32 v16, 16, v40
  v_and_b32 v17, 0xffff0000, v40
  v_fmac_f32_dpp v8, v26, v16 row_newbcast:10 row_mask:0xf bank_mask:0xf
  v_fmac_f32_dpp v9, v26, v17 row_newbcast:10 row_mask:0xf bank_mask:0xf
  v_lshlrev_b32 v18, 16, v41
  v_and_b32 v19, 0xffff0000, v41
  v_fmac_f32_dpp v10, v26, v18 row_newbcast:10 row_mask:0xf bank_mask:0xf
  v_fmac_f32_dpp v11, v26, v19 row_newbcast:10 row_mask:0xf bank_mask:0xf
  v_lshlrev_b32 v16, 16, v42
  v_and_b32 v17, 0xffff0000, v42
  v_fmac_f32_dpp v12, v26, v16 row_newbcast:10 row_mask:0xf bank_mask:0xf
  v_fmac_f32_dpp v13, v26, v17 row_newbcast:10 row_mask:0xf bank_mask:0xf
  v_lshlrev_b32 v18, 16, v43
  v_and_b32 v19, 0xffff0000, v43
  v_fmac_f32_dpp v14, v26, v18 row_newbcast:10 row_mask:0xf bank_mask:0xf
  v_fmac_f32_dpp v15, v26, v19 row_newbcast:10 row_mask:0xf bank_mask:0xf
  v_lshlrev_b32 v16, 16, v44
  v_and_b32 v17, 0xffff0000, v44
  v_fmac_f32_dpp v8, v26, v16 row_newbcast:11 row_mask:0xf bank_mask:0xf
  v_fmac_f32_dpp v9, v26, v17 row_newbcast:11 row_mask:0xf bank_mask:0xf
  v_lshlrev_b32 v18, 16, v45
  v_and_b32 v19, 0xffff0000, v45
  v_fmac_f32_dpp v10, v26, v18 row_newbcast:11 row_mask:0xf bank_mask:0xf
  v_fmac_f32_dpp v11, v26, v19 row_newbcast:11 row_mask:0xf bank_mask:0xf
  v_lshlrev_b32 v16, 16, v46
  v_and_b32 v17, 0xffff0000, v46
  v_fmac_f32_dpp v12, v26, v16 row_newbcast:11 row_mask:0xf bank_mask:0xf
  v_fmac_f32_dpp v13, v26, v17 row_newbcast:11 row_mask:0xf bank_mask:0xf
  v_lshlrev_b32 v18, 16, v47
  v_and_b32 v19, 0xffff0000, v47
  v_fmac_f32_dpp v14, v26, v18 row_newbcast:11 row_mask:0xf bank_mask:0xf
  v_fmac_f32_dpp v15, v26, v19 row_newbcast:11 row_mask:0xf bank_mask:0xf
  s_bitcmp0_b32 s46, 1
  s_cbranch_scc1 L_nt27
  s_waitcnt vmcnt(4)
L_nt27:
  s_bitcmp0_b32 s46, 5
  s_cbranch_scc1 L_nt28
  s_waitcnt vmcnt(2)
L_nt28:
  buffer_load_dwordx4 v[40:43], v1, s[16:19], s29 offen offset:0 nt
  buffer_load_dwordx4 v[44:47], v1, s[16:19], s29 offen offset:1024 nt
  s_add_u32 s29, s29, 8192
  s_waitcnt vmcnt(6)
  v_lshlrev_b32 v16, 16, v48
  v_and_b32 v17, 0xffff0000, v48
  v_fmac_f32_dpp v8, v26, v16 row_newbcast:12 row_mask:0xf bank_mask:0xf
  v_fmac_f32_dpp v9, v26, v17 row_newbcast:12 row_mask:0xf bank_mask:0xf
  v_lshlrev_b32 v18, 16, v49
  v_and_b32 v19, 0xffff0000, v49
  v_fmac_f32_dpp v10, v26, v18 row_newbcast:12 row_mask:0xf bank_mask:0xf
  v_fmac_f32_dpp v11, v26, v19 row_newbcast:12 row_mask:0xf bank_mask:0xf
  v_lshlrev_b32 v16, 16, v50
  v_and_b32 v17, 0xffff0000, v50
  v_fmac_f32_dpp v12, v26, v16 row_newbcast:12 row_mask:0xf bank_mask:0xf
  v_fmac_f32_dpp v13, v26, v17 row_newbcast:12 row_mask:0xf bank_mask:0xf
  v_lshlrev_b32 v18, 16, v51
  v_and_b32 v19, 0xffff0000, v51
  v_fmac_f32_dpp v14, v26, v18 row_newbcast:12 row_mask:0xf bank_mask:0xf
  v_fmac_f32_dpp v15, v26, v19 row_newbcast:12 row_mask:0xf bank_mask:0xf
  v_lshlrev_b32 v16, 16, v52
  v_and_b32 v17, 0xffff0000, v52
  v_fmac_f32_dpp v8, v26, v16 row_newbcast:13 row_mask:0xf bank_mask:0xf
  v_fmac_f32_dpp v9, v26, v17 row_newbcast:13 row_mask:0xf bank_mask:0xf
  v_lshlrev_b32 v18, 16, v53
  v_and_b32 v19, 0xffff0000, v53
  v_fmac_f32_dpp v10, v26, v18 row_newbcast:13 row_mask:0xf bank_mask:0xf
  v_fmac_f32_dpp v11, v26, v19 row_newbcast:13 row_mask:0xf bank_mask:0xf
  v_lshlrev_b32 v16, 16, v54
  v_and_b32 v17, 0xffff0000, v54
  v_fmac_f32_dpp v12, v26, v16 row_newbcast:13 row_mask:0xf bank_mask:0xf
  v_fmac_f32_dpp v13, v26, v17 row_newbcast:13 row_mask:0xf bank_mask:0xf
  v_lshlrev_b32 v18, 16, v55
  v_and_b32 v19, 0xffff0000, v55
  v_fmac_f32_dpp v14, v26, v18 row_newbcast:13 row_mask:0xf bank_mask:0xf
  v_fmac_f32_dpp v15, v26, v19 row_newbcast:13 row_mask:0xf bank_mask:0xf
  s_bitcmp0_b32 s46, 2
  s_cbranch_scc1 L_nt29
  s_waitcnt vmcnt(4)
L_nt29:
  s_bitcmp0_b32 s46, 6
  s_cbranch_scc1 L_nt30
  s_waitcnt vmcnt(2)
L_nt30:
  buffer_load_dwordx4 v[48:51], v1, s[16:19], s29 offen offset:0 nt
  buffer_load_dwordx4 v[52:55], v1, s[16:19], s29 offen offset:1024 nt
  s_add_u32 s29, s29, 8192
  s_memrealtime s[52:53]
  s_waitcnt vmcnt(6)
  v_lshlrev_b32 v16, 16, v56
  v_and_b32 v17, 0xffff0000, v56
  v_fmac_f32_dpp v8, v26, v16 row_newbcast:14 row_mask:0xf bank_mask:0xf
  v_fmac_f32_dpp v9, v26, v17 row_newbcast:14 row_mask:0xf bank_mask:0xf
  v_lshlrev_b32 v18, 16, v57
  v_and_b32 v19, 0xffff0000, v57
  v_fmac_f32_dpp v10, v26, v18 row_newbcast:14 row_mask:0xf bank_mask:0xf
  v_fmac_f32_dpp v11, v26, v19 row_newbcast:14 row_mask:0xf bank_mask:0xf
  v_lshlrev_b32 v16, 16, v58
  v_and_b32 v17, 0xffff0000, v58
  v_fmac_f32_dpp v12, v26, v16 row_newbcast:14 row_mask:0xf bank_mask:0xf
  v_fmac_f32_dpp v13, v26, v17 row_newbcast:14 row_mask:0xf bank_mask:0xf
  v_lshlrev_b32 v18, 16, v59
  v_and_b32 v19, 0xffff0000, v59
  v_fmac_f32_dpp v14, v26, v18 row_newbcast:14 row_mask:0xf bank_mask:0xf
  v_fmac_f32_dpp v15, v26, v19 row_newbcast:14 row_mask:0xf bank_mask:0xf
  v_lshlrev_b32 v16, 16, v60
  v_and_b32 v17, 0xffff0000, v60
  v_fmac_f32_dpp v8, v26, v16 row_newbcast:15 row_mask:0xf bank_mask:0xf
  v_fmac_f32_dpp v9, v26, v17 row_newbcast:15 row_mask:0xf bank_mask:0xf
  v_lshlrev_b32 v18, 16, v61
  v_and_b32 v19, 0xffff0000, v61
  v_fmac_f32_dpp v10, v26, v18 row_newbcast:15 row_mask:0xf bank_mask:0xf
  v_fmac_f32_dpp v11, v26, v19 row_newbcast:15 row_mask:0xf bank_mask:0xf
  v_lshlrev_b32 v16, 16, v62
  v_and_b32 v17, 0xffff0000, v62
  v_fmac_f32_dpp v12, v26, v16 row_newbcast:15 row_mask:0xf bank_mask:0xf
  v_fmac_f32_dpp v13, v26, v17 row_newbcast:15 row_mask:0xf bank_mask:0xf
  v_lshlrev_b32 v18, 16, v63
  v_and_b32 v19, 0xffff0000, v63
  v_fmac_f32_dpp v14, v26, v18 row_newbcast:15 row_mask:0xf bank_mask:0xf
  v_fmac_f32_dpp v15, v26, v19 row_newbcast:15 row_mask:0xf bank_mask:0xf
  s_bitcmp0_b32 s46, 3
  s_cbranch_scc1 L_nt31
  s_waitcnt vmcnt(4)
L_nt31:
  s_bitcmp0_b32 s46, 7
  s_cbranch_scc1 L_nt32
  s_waitcnt vmcnt(2)
L_nt32:
  buffer_load_dwordx4 v[56:59], v1, s[16:19], s29 offen offset:0 nt
  buffer_load_dwordx4 v[60:63], v1, s[16:19], s29 offen offset:1024 nt
  s_add_u32 s29, s29, 8192
  s_waitcnt lgkmcnt(0)
  s_sub_u32 s54, s52, s36
  s_lshl_b32 s54, s54, 3
  s_add_u32 s55, s55, 1769
  s_cmp_lt_u32 s54, s55
  s_cselect_b32 s46, 15, 0
  s_sub_u32 s53, s55, 640
  s_cmp_lt_i32 s54, s53
  s_cselect_b32 s46, 240, s46
  s_sub_u32 s31, s31, 1
  s_cmp_lg_u32 s31, 0
  s_cbranch_scc1 L_p2
  s_nop 1
  v_add_f32_dpp v7, v7, v7 quad_perm:[1,0,3,2] row_mask:0xf bank_mask:0xf
  s_nop 1
  v_add_f32_dpp v7, v7, v7 quad_perm:[2,3,0,1] row_mask:0xf bank_mask:0xf
  s_nop 1
  v_add_f32_dpp v7, v7, v7 row_half_mirror row_mask:0xf bank_mask:0xf
  s_nop 1
  v_add_f32_dpp v7, v7, v7 row_mirror row_mask:0xf bank_mask:0xf
  s_waitcnt vmcnt(0) lgkmcnt(0)
  v_mov_b32 v32, v7
  v_mov_b32 v33, v8
  v_mov_b32 v34, v9
  v_mov_b32 v35, v10
  v_mov_b32 v36, v11
  v_mov_b32 v37, v12
  v_mov_b32 v38, v13
  v_mov_b32 v39, v14
  v_mov_b32 v40, v15
  s_nop 1
  v_permlane16_swap_b32 v7, v32
  v_permlane16_swap_b32 v8, v33
  v_permlane16_swap_b32 v9, v34
  v_permlane16_swap_b32 v10, v35
  v_permlane16_swap_b32 v11, v36
  v_permlane16_swap_b32 v12, v37
  v_permlane16_swap_b32 v13, v38
  v_permlane16_swap_b32 v14, v39
  v_permlane16_swap_b32 v15, v40
  s_nop 1
  v_add_f32 v7, v7, v32
  v_add_f32 v8, v8, v33
  v_add_f32 v9, v9, v34
  v_add_f32 v10, v10, v35
  v_add_f32 v11, v11, v36
  v_add_f32 v12, v12, v37
  v_add_f32 v13, v13, v38
  v_add_f32 v14, v14, v39
  v_add_f32 v15, v15, v40
  v_mov_b32 v32, v7
  v_mov_b32 v33, v8
  v_mov_b32 v34, v9
  v_mov_b32 v35, v10
  v_mov_b32 v36, v11
  v_mov_b32 v37, v12
  v_mov_b32 v38, v13
  v_mov_b32 v39, v14
  v_mov_b32 v40, v15
  s_nop 1
  v_permlane32_swap_b32 v7, v32
  v_permlane32_swap_b32 v8, v33
  v_permlane32_swap_b32 v9, v34
  v_permlane32_swap_b32 v10, v35
  v_permlane32_swap_b32 v11, v36
  v_permlane32_swap_b32 v12, v37
  v_permlane32_swap_b32 v13, v38
  v_permlane32_swap_b32 v14, v39
  v_permlane32_swap_b32 v15, v40
  s_nop 1
  v_add_f32 v7, v7, v32
  v_add_f32 v8, v8, v33
  v_add_f32 v9, v9, v34
  v_add_f32 v10, v10, v35
  v_add_f32 v11, v11, v36
  v_add_f32 v12, v12, v37
  v_add_f32 v13, v13, v38
  v_add_f32 v14, v14, v39
  v_add_f32 v15, v15, v40
  v_lshrrev_b32 v17, 6, v0
  v_and_b32 v18, 15, v0
  v_lshlrev_b32 v18, 5, v18
  v_lshl_add_u32 v18, v17, 9, v18
  v_lshlrev_b32 v19, 2, v17
  v_and_b32 v16, 63, v0
  v_cmp_gt_u32 vcc, 16, v16
  s_and_saveexec_b64 s[32:33], vcc
  ds_write_b128 v18, v[8:11] offset:16384
  ds_write_b128 v18, v[12:15] offset:16400
  ds_write_b32 v19, v24 offset:18432
  ds_write_b32 v19, v7 offset:18496
  s_mov_b64 exec, s[32:33]
  s_waitcnt lgkmcnt(0)
  s_barrier
  v_readfirstlane_b32 s34, v0
  s_nop 3
  s_cmp_ge_u32 s34, 64
  s_cbranch_scc1 L_end
  v_mov_b32 v16, 0
  ds_read_b128 v[32:35], v16 offset:18432
  ds_read_b128 v[36:39], v16 offset:18496
  v_lshlrev_b32 v17, 3, v0
  ds_read_b64 v[40:41], v17 offset:16384
  ds_read_b64 v[42:43], v17 offset:16896
  ds_read_b64 v[44:45], v17 offset:17408
  ds_read_b64 v[46:47], v17 offset:17920
  s_waitcnt lgkmcnt(0)
  v_max_f32 v24, v32, v33
  v_max3_f32 v24, v24, v34, v35
  v_mul_f32 v25, s30, v24
  v_fma_f32 v32, v32, s30, -v25
  v_fma_f32 v33, v33, s30, -v25
  v_fma_f32 v34, v34, s30, -v25
  v_fma_f32 v35, v35, s30, -v25
  v_exp_f32 v32, v32
  v_exp_f32 v33, v33
  v_exp_f32 v34, v34
  v_exp_f32 v35, v35
  s_nop 0
  v_mul_f32 v7, v32, v36
  v_mul_f32 v8, v32, v40
  v_mul_f32 v9, v32, v41
  v_fmac_f32 v7, v33, v37
  v_fmac_f32 v8, v33, v42
  v_fmac_f32 v9, v33, v43
  v_fmac_f32 v7, v34, v38
  v_fmac_f32 v8, v34, v44
  v_fmac_f32 v9, v34, v45
  v_fmac_f32 v7, v35, v39
  v_fmac_f32 v8, v35, v46
  v_fmac_f32 v9, v35, v47
  v_rcp_f32 v7, v7
  s_nop 0
  v_mul_f32 v8, v8, v7
  v_mul_f32 v9, v9, v7
  v_cvt_pk_bf16_f32 v8, v8, v9
  v_lshlrev_b32 v17, 2, v0
  buffer_store_dword v8, v17, s[24:27], 0 offen
L_end:
  s_endpgm
.section .rodata,"a"
.p2align 6
.amdhsa_kernel standalone__softmax_full_bidir__decode_kernel
  .amdhsa_next_free_vgpr 64
  .amdhsa_next_free_sgpr 96
  .amdhsa_accum_offset 64
  .amdhsa_group_segment_fixed_size 0
  .amdhsa_kernarg_size 48
  .amdhsa_user_sgpr_count 2
  .amdhsa_user_sgpr_kernarg_segment_ptr 1
  .amdhsa_system_sgpr_workgroup_id_x 1
.end_amdhsa_kernel
```
